```python
import torch

def _softmax(x, axis=-1):
    return torch.softmax(x, dim=axis)
def _gelu(x):
    return torch.nn.functional.gelu(x, approximate="tanh")
def _silu(x):
    return torch.nn.functional.silu(x)
def _sigmoid(x):
    return torch.sigmoid(x)
def _layernorm(x, axis=-1, eps=1e-5):
    m = x.mean(dim=axis, keepdim=True)
    v = x.var(dim=axis, keepdim=True, unbiased=False)
    return (x - m) / torch.sqrt(v + eps)
def _scatter_add(tgt, idx, src, axis=0):
    return tgt.clone().index_add_(axis, idx, src)
def _segment_sum(src, seg, n):
    out = torch.zeros((n,) + src.shape[1:], dtype=src.dtype)
    return out.index_add_(0, seg, src)
def _pad(x, pw):
    flat = tuple(v for pair in reversed(pw) for v in pair)
    return torch.nn.functional.pad(x, flat)

kernel_name = 'standalone__weight_only_int_quip__decode'

def setup_inputs():

    _w = (lambda a: (lambda t: t.to(torch.bfloat16) if t.is_floating_point() else t)(torch.as_tensor(a)))
    B, S, D, F = 4, 1, 576, 4608
    G = 32 if 32 > 0 else D
    D = (D // G) * G
    ng = D // G
    bits = 4 if 4 > 0 else 4
    qmax = 1 << bits
    qw = torch.randint(0, qmax, (D, F)).to(torch.int32)
    U, _ = (lambda *_a, **_k: torch.linalg.qr(*[torch.as_tensor(_x).float() for _x in _a], **_k))((lambda *s: torch.randn(*s, dtype=torch.bfloat16) * 0.05)(D, D))
    V, _ = (lambda *_a, **_k: torch.linalg.qr(*[torch.as_tensor(_x).float() for _x in _a], **_k))((lambda *s: torch.randn(*s, dtype=torch.bfloat16) * 0.05)(F, F))
    return {
        "x": _w((lambda *s: torch.randn(*s, dtype=torch.bfloat16) * 0.05)(B, S, D)),
        "qw": _w(qw),
        "scales": _w(torch.abs((lambda *s: torch.randn(*s, dtype=torch.bfloat16) * 0.05)(ng, F)) * 0.02 + 0.005),
        "zeros": _w(torch.full((ng, F), qmax / 2.0, dtype=float)),
        "U": _w(U.to(float)),
        "V": _w(V.to(float)),
    }

def reference(x, qw, scales, zeros, U, V):
    B, S, D = x.shape
    ng, F = scales.shape
    G = D // ng
    s = (lambda x, n, axis: torch.repeat_interleave(x, n, dim=axis))(scales, G, axis=0)
    z = (lambda x, n, axis: torch.repeat_interleave(x, n, dim=axis))(zeros, G, axis=0)
    wq = ((lambda x, dt: x.to(dt))(qw, x.dtype) - z) * s
    xr = torch.einsum("bsd,de->bse", x, U)
    h  = torch.einsum("bse,ef->bsf", xr, wq)
    y  = torch.einsum("bsf,fg->bsg", h, V)
    return y
```

```asm
; @launch grid=(256,1,1) block=(704,1,1) lds=163840
.amdgcn_target "amdgcn-amd-amdhsa--gfx950"
.text
.globl standalone__weight_only_int_quip__decode_kernel
.p2align 8
.type standalone__weight_only_int_quip__decode_kernel,@function
standalone__weight_only_int_quip__decode_kernel:
s_cmp_ge_u32 s2, 256
s_cbranch_scc1 L_END
s_load_dwordx2 s[24:25], s[0:1], 8
s_getpc_b64 s[8:9]
L_PC:
v_lshlrev_b32 v14, 4, v0
v_min_u32 v14, L_CODE_END-L_PC-4, v14
global_load_dword v124, v14, s[8:9]
s_load_dwordx2 s[48:49], s[0:1], 32
s_load_dwordx2 s[52:53], s[0:1], 0
s_load_dwordx2 s[40:41], s[0:1], 64
s_memrealtime s[66:67]
v_readfirstlane_b32 s6, v0
s_bfe_u32 s4, s2, 0x30003
s_and_b32 s5, s2, 7
s_lshl_b32 s5, s5, 2
s_lshr_b32 s3, s2, 6
s_add_u32 s5, s5, s3
v_and_b32 v2, 63, v0
v_mov_b32 v13, 0
s_lshr_b32 s6, s6, 6
s_cbranch_scc1 L_NOTL
s_mov_b32 s26, 10616832
s_mov_b32 s27, 0x00020000
v_mul_u32_u24 v14, 1821, v2
v_lshlrev_b32 v15, 4, v2
s_movk_i32 s13, 17856
s_mul_i32 s12, s4, 72*18432
s_mul_i32 s14, s5, 576
s_add_u32 s12, s12, s14
s_mov_b32 m0, 122368
v_lshrrev_b32 v16, 16, v14
v_mad_u32_u24 v16, v16, s13, v15
s_cmp_ge_u32 s2, 36
s_cbranch_scc1 L_QGO
s_barrier
L_QGO:
s_waitcnt lgkmcnt(0)
s_load_dwordx2 s[36:37], s[0:1], 40
buffer_load_dwordx4 v16, s[24:27], s12 offen offset:0 nt lds
v_add_u32 v14, 116544, v14
v_lshrrev_b32 v17, 16, v14
v_mad_u32_u24 v17, v17, s13, v15
buffer_load_dwordx4 v17, s[24:27], s12 offen offset:1024 nt lds
v_add_u32 v14, 116544, v14
v_lshrrev_b32 v18, 16, v14
v_mad_u32_u24 v18, v18, s13, v15
buffer_load_dwordx4 v18, s[24:27], s12 offen offset:2048 nt lds
v_add_u32 v14, 116544, v14
v_lshrrev_b32 v19, 16, v14
v_mad_u32_u24 v19, v19, s13, v15
buffer_load_dwordx4 v19, s[24:27], s12 offen offset:3072 nt lds
v_add_u32 v14, 116544, v14
s_add_u32 m0, m0, 4096
s_add_u32 s12, s12, 4096
v_lshrrev_b32 v20, 16, v14
v_mad_u32_u24 v20, v20, s13, v15
buffer_load_dwordx4 v20, s[24:27], s12 offen offset:0 nt lds
v_add_u32 v14, 116544, v14
v_lshrrev_b32 v21, 16, v14
v_mad_u32_u24 v21, v21, s13, v15
buffer_load_dwordx4 v21, s[24:27], s12 offen offset:1024 nt lds
v_add_u32 v14, 116544, v14
v_lshrrev_b32 v22, 16, v14
v_mad_u32_u24 v22, v22, s13, v15
buffer_load_dwordx4 v22, s[24:27], s12 offen offset:2048 nt lds
v_add_u32 v14, 116544, v14
v_lshrrev_b32 v23, 16, v14
v_mad_u32_u24 v23, v23, s13, v15
buffer_load_dwordx4 v23, s[24:27], s12 offen offset:3072 nt lds
v_add_u32 v14, 116544, v14
s_add_u32 m0, m0, 4096
s_add_u32 s12, s12, 4096
v_lshrrev_b32 v24, 16, v14
v_mad_u32_u24 v24, v24, s13, v15
buffer_load_dwordx4 v24, s[24:27], s12 offen offset:0 nt lds
s_mov_b32 s16, 1
s_cmp_lt_u32 s2, 36
s_cbranch_scc1 L_QLOOPX
L_QLOOP:
s_add_u32 m0, m0, 1024
s_add_u32 s12, s12, 286720
s_waitcnt vmcnt(17)
buffer_load_dwordx4 v16, s[24:27], s12 offen offset:0 nt lds
s_waitcnt vmcnt(17)
buffer_load_dwordx4 v17, s[24:27], s12 offen offset:1024 nt lds
s_waitcnt vmcnt(17)
buffer_load_dwordx4 v18, s[24:27], s12 offen offset:2048 nt lds
s_waitcnt vmcnt(17)
buffer_load_dwordx4 v19, s[24:27], s12 offen offset:3072 nt lds
s_add_u32 m0, m0, 4096
s_add_u32 s12, s12, 4096
s_cmp_eq_u32 s16, 4
s_cselect_b32 exec_hi, 0, -1
s_waitcnt vmcnt(17)
buffer_load_dwordx4 v20, s[24:27], s12 offen offset:0 nt lds
s_cbranch_scc1 L_QDONE
s_waitcnt vmcnt(17)
buffer_load_dwordx4 v21, s[24:27], s12 offen offset:1024 nt lds
s_waitcnt vmcnt(17)
buffer_load_dwordx4 v22, s[24:27], s12 offen offset:2048 nt lds
s_waitcnt vmcnt(17)
buffer_load_dwordx4 v23, s[24:27], s12 offen offset:3072 nt lds
s_add_u32 m0, m0, 4096
s_add_u32 s12, s12, 4096
s_cmp_lg_u32 s16, 1
s_cbranch_scc1 L_QNB
s_barrier
L_QNB:
s_waitcnt vmcnt(17)
buffer_load_dwordx4 v24, s[24:27], s12 offen offset:0 nt lds
s_add_u32 s16, s16, 1
s_branch L_QLOOP
L_NOTL:
s_cmp_eq_u32 s6, 1
s_cbranch_scc1 L_AUX
v_lshlrev_b32 v14, 2, v2
ds_write_b32 v14, v13 offset:2048
v_lshrrev_b32 v8, 3, v2
v_and_b32 v9, 6, v8
v_and_b32 v10, 7, v2
v_xor_b32 v9, v9, v10
s_cmp_ge_u32 s2, 36
s_cbranch_scc1 L_NOU
s_mul_i32 s10, s2, 57
s_lshr_b32 s10, s10, 9
s_mul_i32 s11, s10, 9
s_sub_u32 s11, s2, s11
s_mov_b32 s50, 663552
s_mov_b32 s51, 0x00020000
v_mul_u32_u24 v12, 1152, v8
v_lshl_add_u32 v12, v9, 4, v12
s_mul_i32 s14, s10, 144*1152
s_lshl_b32 s13, s11, 7
s_add_u32 s14, s14, s13
s_mul_i32 s13, s6, 16*1152
s_add_u32 s14, s14, s13
s_sub_u32 s14, s14, 36864
s_lshl_b32 s13, s6, 11
s_add_u32 m0, s13, 99840
s_add_u32 s15, s14, 8192
s_waitcnt lgkmcnt(0)
buffer_load_dwordx4 v12, s[48:51], s14 offen nt lds
buffer_load_dwordx4 v12, s[48:51], s15 offen offset:1024 nt lds
L_NOU:
s_waitcnt lgkmcnt(0)
s_load_dwordx2 s[36:37], s[0:1], 40
s_load_dwordx2 s[44:45], s[0:1], 48
s_load_dword s7, s[40:41], 0
s_barrier
s_branch L_COMP
L_AUX:
v_mul_u32_u24 v27, 3641, v2
v_lshrrev_b32 v27, 16, v27
v_lshlrev_b32 v29, 4, v2
v_lshlrev_b32 v14, 7, v2
s_cmp_ge_u32 s2, 36
s_cbranch_scc1 L_NOXL
s_mov_b32 s54, 4608
s_mov_b32 s55, 0x00020000
s_mul_i32 s10, s2, 57
s_lshr_b32 s10, s10, 9
v_mul_u32_u24 v28, 864, v27
v_add_u32 v28, v28, v29
s_mul_i32 s17, s10, 288
s_mov_b32 m0, 4352
s_add_u32 s18, s17, 3*864
s_waitcnt lgkmcnt(0)
buffer_load_dwordx4 v28, s[52:55], s17 offen lds
s_mov_b64 exec, 0xff
buffer_load_dwordx4 v29, s[52:55], s18 offen offset:1024 lds
s_cmp_lg_u32 s2, 0
s_cbranch_scc1 L_NOZ
global_store_dword v14, v13, s[40:41] offset:1024 sc1
L_NOZ:
s_mov_b64 exec, -1
L_NOXL:
s_load_dwordx2 s[28:29], s[0:1], 16
s_load_dwordx2 s[32:33], s[0:1], 24
s_load_dwordx2 s[36:37], s[0:1], 40
s_load_dwordx2 s[44:45], s[0:1], 48
s_barrier
s_mov_b32 s30, 165888
s_mov_b32 s31, 0x00020000
s_mov_b32 s34, 165888
s_mov_b32 s35, 0x00020000
s_mov_b32 s42, 4194304
s_mov_b32 s43, 0x00020000
v_mul_u32_u24 v27, 8928, v27
v_add_u32 v27, v27, v29
s_mul_i32 s16, s4, 9
s_lshr_b32 s16, s16, 2
s_mul_i32 s16, s16, 9216
s_mul_i32 s17, s5, 288
s_add_u32 s16, s16, s17
s_mov_b32 m0, 2304
s_mov_b32 exec_hi, 0x3fffff
s_waitcnt lgkmcnt(0)
s_load_dword s7, s[40:41], 0
buffer_load_dwordx4 v27, s[28:31], s16 offen lds
s_mov_b32 m0, 3328
s_nop 0
buffer_load_dwordx4 v27, s[32:35], s16 offen lds
s_mov_b64 exec, 3
s_mul_i32 s20, s5, 144*9216
v_mul_u32_u24 v30, 1327100, v2
v_add_u32 v30, s20, v30
global_load_dword v31, v30, s[36:37]
v_mul_u32_u24 v30, 4193280, v2
global_load_dword v32, v30, s[40:41] offset:512
global_load_dword v33, v13, s[44:45]
s_mul_i32 s20, s4, 72*18432
s_add_u32 s20, s20, 1327100
v_mov_b32 v30, s20
global_load_dword v34, v30, s[24:25]
s_mov_b64 exec, -1
s_lshl_b32 s3, s5, 3
s_add_u32 s3, s3, s4
s_mul_i32 s8, s3, 2304
s_add_u32 s8, s8, 196608
v_mov_b32 v20, 0
v_mov_b32 v21, 0
v_mov_b32 v22, 0
v_mov_b32 v23, 0
buffer_store_dwordx4 v[20:23], v29, s[40:43], s8 offen
buffer_store_dwordx4 v[20:23], v29, s[40:43], s8 offen offset:1024
s_mov_b64 exec, 0xffff
buffer_store_dwordx4 v[20:23], v29, s[40:43], s8 offen offset:2048
s_mov_b64 exec, -1
s_branch L_SYNC
L_QLOOPX:
s_add_u32 m0, m0, 1024
s_add_u32 s12, s12, 286720
s_waitcnt vmcnt(29)
buffer_load_dwordx4 v16, s[24:27], s12 offen offset:0 nt lds
s_waitcnt vmcnt(29)
buffer_load_dwordx4 v17, s[24:27], s12 offen offset:1024 nt lds
s_waitcnt vmcnt(29)
buffer_load_dwordx4 v18, s[24:27], s12 offen offset:2048 nt lds
s_waitcnt vmcnt(29)
buffer_load_dwordx4 v19, s[24:27], s12 offen offset:3072 nt lds
s_add_u32 m0, m0, 4096
s_add_u32 s12, s12, 4096
s_cmp_eq_u32 s16, 4
s_cselect_b32 exec_hi, 0, -1
s_waitcnt vmcnt(29)
buffer_load_dwordx4 v20, s[24:27], s12 offen offset:0 nt lds
s_cbranch_scc1 L_QDONE
s_waitcnt vmcnt(29)
buffer_load_dwordx4 v21, s[24:27], s12 offen offset:1024 nt lds
s_waitcnt vmcnt(29)
buffer_load_dwordx4 v22, s[24:27], s12 offen offset:2048 nt lds
s_waitcnt vmcnt(29)
buffer_load_dwordx4 v23, s[24:27], s12 offen offset:3072 nt lds
s_add_u32 m0, m0, 4096
s_add_u32 s12, s12, 4096
s_waitcnt vmcnt(29)
buffer_load_dwordx4 v24, s[24:27], s12 offen offset:0 nt lds
s_add_u32 s16, s16, 1
s_branch L_QLOOPX
L_QDONE:
s_mov_b32 exec_hi, -1
s_mov_b32 s38, 42467328
s_mov_b32 s39, 0x00020000
s_mov_b32 s42, 4194304
s_mov_b32 s43, 0x00020000
v_lshrrev_b32 v8, 3, v2
v_and_b32 v9, 6, v8
v_and_b32 v10, 7, v2
v_xor_b32 v9, v9, v10
v_mul_u32_u24 v11, 9216, v8
v_lshl_add_u32 v11, v9, 4, v11
s_mul_i32 s20, s5, 144*9216
s_mul_i32 s21, s4, 1152
s_add_u32 s20, s20, s21
s_lshl_b32 s3, s5, 3
s_add_u32 s3, s3, s4
v_mov_b32 v26, 1
s_add_u32 s12, s20, 1179648
s_mov_b32 s15, 7168
s_mov_b32 s16, 0
s_mov_b32 s14, 0
s_waitcnt lgkmcnt(0)
s_add_u32 s66, s66, 205
L_V1:
s_add_u32 m0, s15, 0
s_waitcnt vmcnt(17)
buffer_load_dwordx4 v11, s[36:39], s12 offen offset:0 nt lds
s_add_u32 m0, s15, 896
s_waitcnt vmcnt(17)
buffer_load_dwordx4 v11, s[36:39], s12 offen offset:128 nt lds
s_add_u32 m0, s15, 1792
s_waitcnt vmcnt(17)
buffer_load_dwordx4 v11, s[36:39], s12 offen offset:256 nt lds
s_add_u32 m0, s15, 2688
s_waitcnt vmcnt(17)
buffer_load_dwordx4 v11, s[36:39], s12 offen offset:384 nt lds
s_add_u32 m0, s15, 3584
s_waitcnt vmcnt(17)
buffer_load_dwordx4 v11, s[36:39], s12 offen offset:512 nt lds
s_add_u32 m0, s15, 4480
s_waitcnt vmcnt(17)
buffer_load_dwordx4 v11, s[36:39], s12 offen offset:640 nt lds
s_add_u32 m0, s15, 5376
s_waitcnt vmcnt(17)
buffer_load_dwordx4 v11, s[36:39], s12 offen offset:768 nt lds
s_add_u32 m0, s15, 6272
s_waitcnt vmcnt(17)
buffer_load_dwordx4 v11, s[36:39], s12 offen offset:896 nt lds
s_add_u32 m0, s15, 7168
s_waitcnt vmcnt(17)
buffer_load_dwordx4 v11, s[36:39], s12 offen offset:1024 nt lds
L_VT:
s_add_u32 s12, s12, 73728
s_cmp_eq_u32 s16, 0
s_cselect_b32 s12, s20, s12
s_add_u32 s15, s15, 9216
s_memrealtime s[68:69]
ds_read_b32 v36, v13 offset:2096
s_add_u32 s16, s16, 1
v_mov_b32 v34, s16
ds_write_b32 v13, v34 offset:2084
s_cmp_eq_u32 s16, 2
s_cbranch_scc0 L_VNQ
s_waitcnt vmcnt(18)
ds_write_b32 v13, v26 offset:2052
L_VNQ:
s_cmp_eq_u32 s16, 10
s_cbranch_scc0 L_VNW
s_mov_b32 s22, 33554432
L_WQ:
ds_read_b32 v14, v13 offset:2068
s_waitcnt lgkmcnt(0)
v_readfirstlane_b32 s23, v14
s_cmp_ge_u32 s23, 9
s_cbranch_scc1 L_WQ_D
s_sleep 1
s_sub_u32 s22, s22, 1
s_cbranch_scc0 L_WQ
L_WQ_D:
L_VNW:
s_cmp_eq_u32 s16, 17
s_cbranch_scc1 L_VEND
s_waitcnt lgkmcnt(0)
s_sub_u32 s67, s68, s66
v_readfirstlane_b32 s13, v36
s_sub_u32 s67, s67, s13
s_add_u32 s66, s66, 32
s_cmp_lt_i32 s67, 0
s_cbranch_scc1 L_V1
s_add_u32 m0, s15, 0
s_waitcnt vmcnt(35)
buffer_load_dwordx4 v11, s[36:39], s12 offen offset:0 nt lds
s_add_u32 m0, s15, 896
s_waitcnt vmcnt(35)
buffer_load_dwordx4 v11, s[36:39], s12 offen offset:128 nt lds
s_add_u32 m0, s15, 1792
s_waitcnt vmcnt(35)
buffer_load_dwordx4 v11, s[36:39], s12 offen offset:256 nt lds
s_add_u32 m0, s15, 2688
s_waitcnt vmcnt(35)
buffer_load_dwordx4 v11, s[36:39], s12 offen offset:384 nt lds
s_add_u32 m0, s15, 3584
s_waitcnt vmcnt(35)
buffer_load_dwordx4 v11, s[36:39], s12 offen offset:512 nt lds
s_add_u32 m0, s15, 4480
s_waitcnt vmcnt(35)
buffer_load_dwordx4 v11, s[36:39], s12 offen offset:640 nt lds
s_add_u32 m0, s15, 5376
s_waitcnt vmcnt(35)
buffer_load_dwordx4 v11, s[36:39], s12 offen offset:768 nt lds
s_add_u32 m0, s15, 6272
s_waitcnt vmcnt(35)
buffer_load_dwordx4 v11, s[36:39], s12 offen offset:896 nt lds
s_add_u32 m0, s15, 7168
s_waitcnt vmcnt(35)
buffer_load_dwordx4 v11, s[36:39], s12 offen offset:1024 nt lds
s_branch L_VT
L_VEND:
v_lshlrev_b32 v12, 10, v2
s_lshl_b32 s16, s4, 7
s_mul_i32 s21, s4, 128
s_add_u32 s20, s40, s21
s_addc_u32 s21, s41, 0
s_add_u32 s16, s16, 8256
s_lshl_b32 s18, s2, 7
s_add_u32 s18, s18, 8192
s_add_u32 s18, s40, s18
s_addc_u32 s19, s41, 0
s_mov_b32 s17, 1
s_waitcnt vmcnt(36)
s_barrier
ds_read_b32 v14, v13 offset:2080
s_waitcnt vmcnt(18)
s_atomic_add s17, s[20:21], 1024 glc
s_waitcnt vmcnt(0) lgkmcnt(0)
v_readfirstlane_b32 s7, v14
s_cmp_lg_u32 s17, 31
s_cbranch_scc1 L_NL0
s_mov_b32 exec_hi, 0
buffer_store_dword v14, v12, s[40:43], s16 offen sc1
s_waitcnt vmcnt(1)
s_branch L_NL1
L_NL0:
s_waitcnt vmcnt(0)
L_NL1:
s_barrier
L_NOTLAST:
s_mov_b32 s22, 2097152
L_YFL:
s_load_dword s23, s[18:19], 64 glc
s_waitcnt lgkmcnt(0)
s_cmp_eq_u32 s23, s7
s_cbranch_scc1 L_YFLD
s_sub_u32 s22, s22, 1
s_cbranch_scc0 L_YFL
L_YFLD:
s_barrier
L_END:
s_endpgm
L_SYNC:
s_setprio 3
v_mov_b32 v17, 1
v_mov_b32 v5, 0xffffff00
v_lshrrev_b32 v3, 4, v2
v_and_b32 v4, 15, v2
v_bfe_u32 v6, v2, 2, 2
v_and_b32 v7, 3, v2
s_mov_b32 s56, 0x22222222
s_mov_b32 s57, 0x22222222
s_mov_b32 s58, 0x44444444
s_mov_b32 s59, 0x44444444
s_mov_b32 s64, 0x88888888
s_mov_b32 s65, 0x88888888
s_lshl_b32 s3, s5, 3
s_add_u32 s3, s3, s4
s_lshl_b32 s18, s3, 7
s_add_u32 s18, s18, 8192
s_add_u32 s18, s40, s18
s_addc_u32 s19, s41, 0
v_lshrrev_b32 v14, 2, v2
v_mul_u32_u24 v15, 576, v7
v_add_lshl_u32 v15, v15, v14, 4
s_mul_i32 s17, s4, 72*16
s_add_u32 s17, s17, 65536
s_add_u32 s16, s17, 36864
v_lshl_add_u32 v16, v6, 2, v7
v_mul_u32_u24 v16, 48, v16
v_lshl_add_u32 v16, v3, 1, v16
s_lshl_b32 s68, s5, 7
s_add_u32 s68, s68, 4096
s_add_u32 s68, s40, s68
s_addc_u32 s69, s41, 0
s_mov_b32 s44, s66
s_getreg_b32 s66, hwreg(HW_REG_XCC_ID, 0, 4)
s_mov_b64 exec, 1
s_waitcnt vmcnt(9)
ds_add_u32 v13, v17 offset:2088
s_mov_b64 exec, -1
s_waitcnt lgkmcnt(0)
s_add_u32 s60, s7, 1
s_and_b32 s60, s60, 0xff
s_add_u32 s61, s7, 80
s_and_b32 s61, s61, 0xff
s_add_u32 s62, s7, 159
s_and_b32 s62, s62, 0xff
s_add_u32 s63, s7, 238
s_and_b32 s63, s63, 0xff
s_mul_i32 s7, s7, 0x9E3779B1
s_add_u32 s7, s7, 0x7F4A7C15
v_mov_b32 v18, s7
ds_write_b32 v13, v18 offset:2080
s_xor_b32 s67, s7, 0x5bd1e995
s_lshl_b32 s67, s67, 4
s_or_b32 s66, s66, s67
s_lshl_b32 s67, s4, 2
s_mov_b32 s20, s7
s_not_b32 s21, s7
v_mov_b32 v18, 2
s_waitcnt vmcnt(7)
ds_write_b32 v13, v18 offset:2048
s_waitcnt vmcnt(0)
s_atomic_swap s66, s[68:69], s67
s_lshr_b32 s24, s5, 2
s_lshl_b32 s24, s24, 3
s_add_u32 s24, s24, s4
s_lshl_b32 s24, s24, 7
s_add_u32 s24, s24, 49152
s_add_u32 s24, s40, s24
s_addc_u32 s25, s41, 0
s_mov_b64 s[46:47], s[24:25]
s_mov_b32 s22, 2097152
L_SPX:
s_load_dwordx16 s[24:39], s[46:47], 0 glc
s_waitcnt lgkmcnt(0)
s_xor_b32 s8, s24, s7
s_xor_b32 s9, s26, s7
s_xor_b32 s10, s28, s7
s_xor_b32 s11, s30, s7
s_xor_b32 s12, s32, s7
s_xor_b32 s13, s34, s7
s_xor_b32 s14, s36, s7
s_xor_b32 s15, s38, s7
s_or_b64 s[8:9], s[8:9], s[10:11]
s_or_b64 s[12:13], s[12:13], s[14:15]
s_or_b64 s[8:9], s[8:9], s[12:13]
s_cbranch_scc0 L_SPXD
s_sub_u32 s22, s22, 1
s_cbranch_scc0 L_SPX
L_SPXD:
s_mov_b32 s22, 2097152
L_XPOLL:
buffer_load_dwordx4 v[20:23], v15, s[40:43], s17 offen offset:0 sc1
buffer_load_dwordx4 v[24:27], v15, s[40:43], s16 offen offset:0 sc1
buffer_load_dwordx4 v[28:31], v15, s[40:43], s17 offen offset:256 sc1
buffer_load_dwordx4 v[32:35], v15, s[40:43], s16 offen offset:256 sc1
buffer_load_dwordx4 v[36:39], v15, s[40:43], s17 offen offset:512 sc1
buffer_load_dwordx4 v[40:43], v15, s[40:43], s16 offen offset:512 sc1
buffer_load_dwordx4 v[44:47], v15, s[40:43], s17 offen offset:768 sc1
buffer_load_dwordx4 v[48:51], v15, s[40:43], s16 offen offset:768 sc1
s_mov_b32 exec_hi, 0
buffer_load_dwordx4 v[52:55], v15, s[40:43], s17 offen offset:1024 sc1
buffer_load_dwordx4 v[56:59], v15, s[40:43], s16 offen offset:1024 sc1
s_cmp_lg_u32 s22, 2097152
s_cbranch_scc1 L_NOADJ
s_sub_u32 s45, s25, s44
s_sub_u32 s23, s27, s44
s_add_i32 s45, s45, s23
s_sub_u32 s23, s29, s44
s_add_i32 s45, s45, s23
s_sub_u32 s23, s31, s44
s_add_i32 s45, s45, s23
s_sub_u32 s23, s33, s44
s_add_i32 s45, s45, s23
s_sub_u32 s23, s35, s44
s_add_i32 s45, s45, s23
s_sub_u32 s23, s37, s44
s_add_i32 s45, s45, s23
s_sub_u32 s23, s39, s44
s_add_i32 s45, s45, s23
s_ashr_i32 s45, s45, 3
s_max_i32 s45, s45, -300
s_min_i32 s45, s45, 300
v_mov_b32 v18, s45
ds_write_b32 v13, v18 offset:2096
L_NOADJ:
s_mov_b32 s23, 2097152
L_AGP:
s_load_dwordx8 s[8:15], s[68:69], 0 glc
s_waitcnt lgkmcnt(0)
s_xor_b32 s8, s8, s66
s_xor_b32 s9, s9, s66
s_xor_b32 s10, s10, s66
s_xor_b32 s11, s11, s66
s_xor_b32 s12, s12, s66
s_xor_b32 s13, s13, s66
s_xor_b32 s14, s14, s66
s_xor_b32 s15, s15, s66
s_or_b64 s[8:9], s[8:9], s[10:11]
s_or_b64 s[12:13], s[12:13], s[14:15]
s_or_b64 s[8:9], s[8:9], s[12:13]
s_or_b32 s8, s8, s9
s_cmp_lt_u32 s8, 16
s_cbranch_scc1 L_AGD
s_sub_u32 s23, s23, 1
s_cbranch_scc0 L_AGP
L_AGD:
s_cmp_eq_u32 s8, 0
s_cselect_b32 s67, 2, 1
v_mov_b32 v19, s67
s_waitcnt vmcnt(0)
v_cmp_ne_u64 s[24:25], s[20:21], v[52:53]
v_cmp_ne_u64 s[26:27], s[20:21], v[58:59]
s_mov_b32 exec_hi, -1
v_cmp_ne_u64 s[28:29], s[20:21], v[20:21]
v_cmp_ne_u64 s[30:31], s[20:21], v[26:27]
v_cmp_ne_u64 s[32:33], s[20:21], v[28:29]
v_cmp_ne_u64 s[34:35], s[20:21], v[34:35]
v_cmp_ne_u64 s[36:37], s[20:21], v[36:37]
v_cmp_ne_u64 s[38:39], s[20:21], v[42:43]
v_cmp_ne_u64 s[8:9], s[20:21], v[44:45]
v_cmp_ne_u64 vcc, s[20:21], v[50:51]
s_or_b64 vcc, vcc, s[24:25]
s_or_b64 vcc, vcc, s[26:27]
s_or_b64 vcc, vcc, s[28:29]
s_or_b64 vcc, vcc, s[30:31]
s_or_b64 vcc, vcc, s[32:33]
s_or_b64 vcc, vcc, s[34:35]
s_or_b64 vcc, vcc, s[36:37]
s_or_b64 vcc, vcc, s[38:39]
s_or_b64 vcc, vcc, s[8:9]
s_cbranch_scc0 L_XDONE
s_sub_u32 s22, s22, 1
s_cbranch_scc0 L_XPOLL
L_XDONE:
v_add_f32_dpp v22, v22, v22 quad_perm:[1,0,3,2] row_mask:0xf bank_mask:0xf
v_add_f32_dpp v23, v23, v23 quad_perm:[1,0,3,2] row_mask:0xf bank_mask:0xf
v_add_f32_dpp v24, v24, v24 quad_perm:[1,0,3,2] row_mask:0xf bank_mask:0xf
v_add_f32_dpp v25, v25, v25 quad_perm:[1,0,3,2] row_mask:0xf bank_mask:0xf
v_add_f32_dpp v30, v30, v30 quad_perm:[1,0,3,2] row_mask:0xf bank_mask:0xf
v_add_f32_dpp v31, v31, v31 quad_perm:[1,0,3,2] row_mask:0xf bank_mask:0xf
v_add_f32_dpp v32, v32, v32 quad_perm:[1,0,3,2] row_mask:0xf bank_mask:0xf
v_add_f32_dpp v33, v33, v33 quad_perm:[1,0,3,2] row_mask:0xf bank_mask:0xf
v_add_f32_dpp v38, v38, v38 quad_perm:[1,0,3,2] row_mask:0xf bank_mask:0xf
v_add_f32_dpp v39, v39, v39 quad_perm:[1,0,3,2] row_mask:0xf bank_mask:0xf
v_add_f32_dpp v40, v40, v40 quad_perm:[1,0,3,2] row_mask:0xf bank_mask:0xf
v_add_f32_dpp v41, v41, v41 quad_perm:[1,0,3,2] row_mask:0xf bank_mask:0xf
v_add_f32_dpp v46, v46, v46 quad_perm:[1,0,3,2] row_mask:0xf bank_mask:0xf
v_add_f32_dpp v47, v47, v47 quad_perm:[1,0,3,2] row_mask:0xf bank_mask:0xf
v_add_f32_dpp v48, v48, v48 quad_perm:[1,0,3,2] row_mask:0xf bank_mask:0xf
v_add_f32_dpp v49, v49, v49 quad_perm:[1,0,3,2] row_mask:0xf bank_mask:0xf
v_add_f32_dpp v54, v54, v54 quad_perm:[1,0,3,2] row_mask:0xf bank_mask:0xf
v_add_f32_dpp v55, v55, v55 quad_perm:[1,0,3,2] row_mask:0xf bank_mask:0xf
v_add_f32_dpp v56, v56, v56 quad_perm:[1,0,3,2] row_mask:0xf bank_mask:0xf
v_add_f32_dpp v57, v57, v57 quad_perm:[1,0,3,2] row_mask:0xf bank_mask:0xf
v_add_f32_dpp v22, v22, v22 quad_perm:[2,3,0,1] row_mask:0xf bank_mask:0xf
v_add_f32_dpp v23, v23, v23 quad_perm:[2,3,0,1] row_mask:0xf bank_mask:0xf
v_add_f32_dpp v24, v24, v24 quad_perm:[2,3,0,1] row_mask:0xf bank_mask:0xf
v_add_f32_dpp v25, v25, v25 quad_perm:[2,3,0,1] row_mask:0xf bank_mask:0xf
v_add_f32_dpp v30, v30, v30 quad_perm:[2,3,0,1] row_mask:0xf bank_mask:0xf
v_add_f32_dpp v31, v31, v31 quad_perm:[2,3,0,1] row_mask:0xf bank_mask:0xf
v_add_f32_dpp v32, v32, v32 quad_perm:[2,3,0,1] row_mask:0xf bank_mask:0xf
v_add_f32_dpp v33, v33, v33 quad_perm:[2,3,0,1] row_mask:0xf bank_mask:0xf
v_add_f32_dpp v38, v38, v38 quad_perm:[2,3,0,1] row_mask:0xf bank_mask:0xf
v_add_f32_dpp v39, v39, v39 quad_perm:[2,3,0,1] row_mask:0xf bank_mask:0xf
v_add_f32_dpp v40, v40, v40 quad_perm:[2,3,0,1] row_mask:0xf bank_mask:0xf
v_add_f32_dpp v41, v41, v41 quad_perm:[2,3,0,1] row_mask:0xf bank_mask:0xf
v_add_f32_dpp v46, v46, v46 quad_perm:[2,3,0,1] row_mask:0xf bank_mask:0xf
v_add_f32_dpp v47, v47, v47 quad_perm:[2,3,0,1] row_mask:0xf bank_mask:0xf
v_add_f32_dpp v48, v48, v48 quad_perm:[2,3,0,1] row_mask:0xf bank_mask:0xf
v_add_f32_dpp v49, v49, v49 quad_perm:[2,3,0,1] row_mask:0xf bank_mask:0xf
v_add_f32_dpp v54, v54, v54 quad_perm:[2,3,0,1] row_mask:0xf bank_mask:0xf
v_add_f32_dpp v55, v55, v55 quad_perm:[2,3,0,1] row_mask:0xf bank_mask:0xf
v_add_f32_dpp v56, v56, v56 quad_perm:[2,3,0,1] row_mask:0xf bank_mask:0xf
v_add_f32_dpp v57, v57, v57 quad_perm:[2,3,0,1] row_mask:0xf bank_mask:0xf
v_cndmask_b32 v22, v22, v23, s[56:57]
v_cndmask_b32 v22, v22, v24, s[58:59]
v_cndmask_b32 v22, v22, v25, s[64:65]
v_cndmask_b32 v30, v30, v31, s[56:57]
v_cndmask_b32 v30, v30, v32, s[58:59]
v_cndmask_b32 v30, v30, v33, s[64:65]
v_cndmask_b32 v38, v38, v39, s[56:57]
v_cndmask_b32 v38, v38, v40, s[58:59]
v_cndmask_b32 v38, v38, v41, s[64:65]
v_cndmask_b32 v46, v46, v47, s[56:57]
v_cndmask_b32 v46, v46, v48, s[58:59]
v_cndmask_b32 v46, v46, v49, s[64:65]
v_cndmask_b32 v54, v54, v55, s[56:57]
v_cndmask_b32 v54, v54, v56, s[58:59]
v_cndmask_b32 v54, v54, v57, s[64:65]
v_cvt_pk_bf16_f32 v20, v22, v30
v_cvt_pk_bf16_f32 v28, v38, v46
v_cvt_pk_bf16_f32 v36, v54, v54
ds_write_b16 v16, v20 offset:0
ds_write_b16_d16_hi v16, v20 offset:8
ds_write_b16 v16, v28 offset:16
ds_write_b16_d16_hi v16, v28 offset:24
s_mov_b32 exec_hi, 0
ds_write_b16 v16, v36 offset:32
ds_write_b32 v13, v19 offset:2056
s_cmp_eq_u32 s67, 1
s_cbranch_scc1 L_GLOBH
s_mov_b32 s22, 33554432
L_PHL:
ds_read_b32 v14, v13 offset:2084
s_waitcnt lgkmcnt(0)
v_readfirstlane_b32 s23, v14
s_cmp_ge_u32 s23, 8
s_cbranch_scc1 L_PHL_D
s_sleep 1
s_sub_u32 s22, s22, 1
s_cbranch_scc0 L_PHL
L_PHL_D:
s_branch L_SEND
L_GLOBH:
s_mov_b32 s22, 2097152
L_SPH:
s_load_dwordx8 s[8:15], s[18:19], 32 glc
s_waitcnt lgkmcnt(0)
s_xor_b32 s8, s8, s7
s_xor_b32 s9, s9, s7
s_xor_b32 s10, s10, s7
s_xor_b32 s11, s11, s7
s_xor_b32 s12, s12, s7
s_xor_b32 s13, s13, s7
s_xor_b32 s14, s14, s7
s_xor_b32 s15, s15, s7
s_or_b64 s[8:9], s[8:9], s[10:11]
s_or_b64 s[12:13], s[12:13], s[14:15]
s_or_b64 s[8:9], s[8:9], s[12:13]
s_cbranch_scc0 L_SPHD
s_sub_u32 s22, s22, 1
s_cbranch_scc0 L_SPH
L_SPHD:
L_SEND:
ds_write_b32 v13, v17 offset:2060
s_endpgm
L_COMP:
s_mov_b32 s42, 4194304
s_mov_b32 s43, 0x00020000
s_mov_b32 s38, 42467328
s_mov_b32 s39, 0x00020000
s_mov_b32 s46, 36864
s_mov_b32 s47, 0x00020000
v_mov_b32 v5, 0xffffff00
v_lshrrev_b32 v3, 4, v2
v_and_b32 v4, 15, v2
v_bfe_u32 v6, v2, 2, 2
v_and_b32 v7, 3, v2
s_mov_b32 s56, 0x22222222
s_mov_b32 s57, 0x22222222
s_mov_b32 s58, 0x44444444
s_mov_b32 s59, 0x44444444
s_mov_b32 s64, 0x88888888
s_mov_b32 s65, 0x88888888
s_lshl_b32 s3, s5, 3
s_add_u32 s3, s3, s4
v_mul_u32_u24 v11, 9216, v8
v_lshl_add_u32 v11, v9, 4, v11
s_mul_i32 s20, s5, 144*9216
s_mul_i32 s21, s4, 1152
s_add_u32 s20, s20, s21
s_sub_u32 s6, s6, 2
v_and_b32 v89, 1, v3
v_lshl_add_u32 v89, v89, 2, v6
v_lshlrev_b32 v88, 7, v89
v_lshl_add_u32 v88, v7, 3, v88
v_lshrrev_b32 v89, 1, v89
v_lshrrev_b32 v90, 1, v3
v_mov_b32 v60, 1
v_lshlrev_b32 v55, 4, v2
v_mov_b32 v59, s66
s_mul_i32 s66, s3, 2304
s_lshl_b32 s19, s6, 8
s_add_u32 s66, s66, s19
s_add_u32 s66, s66, 196608
s_cmp_ge_u32 s2, 36
s_cbranch_scc1 L_NOX
s_cmp_lt_u32 s6, 4
s_cbranch_scc1 L_XJOB
s_mov_b64 exec, 1
s_waitcnt vmcnt(0)
ds_add_u32 v13, v60 offset:2088
s_mov_b64 exec, -1
s_branch L_NOX
L_XJOB:
s_setprio 2
v_mul_u32_u24 v15, 288, v7
v_lshl_add_u32 v15, v3, 3, v15
v_add_u32 v15, 4352, v15
v_mov_b32 v34, 0
v_mov_b32 v35, 0
v_xor_b32 v56, s6, v89
v_lshl_add_u32 v56, v56, 5, v88
v_lshl_add_u32 v56, v90, 10, v56
v_add_u32 v56, 103936, v56
v_mov_b32 v118, 0
v_mov_b32 v119, 0
s_mul_i32 s17, s10, 576*16
s_lshl_b32 s18, s11, 10
s_add_u32 s17, s17, s18
s_lshl_b32 s18, s6, 8
s_add_u32 s17, s17, s18
s_add_u32 s17, s17, 65536
v_and_b32 v57, 7, v2
v_lshlrev_b32 v57, 10, v57
v_lshrrev_b32 v58, 5, v2
v_mul_u32_u24 v58, 120, v58
v_sub_u32 v57, v57, v58
v_add_u32 v57, 128, v57
s_lshl_b32 s18, s11, 7
s_lshl_b32 s19, s10, 4
s_add_u32 s18, s18, s19
s_add_u32 s18, s18, 49024
s_cmp_eq_u32 s11, 8
s_cselect_b32 s8, 0, 0xff
s_cmp_eq_u32 s11, 0
s_cselect_b32 s9, 0, 0xff
s_waitcnt lgkmcnt(0)
s_add_u32 s60, s7, 1
s_and_b32 s60, s60, 0xff
s_add_u32 s61, s7, 80
s_and_b32 s61, s61, 0xff
s_add_u32 s62, s7, 159
s_and_b32 s62, s62, 0xff
s_add_u32 s63, s7, 238
s_and_b32 s63, s63, 0xff
s_mul_i32 s7, s7, 0x9E3779B1
s_add_u32 s7, s7, 0x7F4A7C15
v_mov_b32 v58, s7
v_mov_b32 v38, s7
v_not_b32 v39, s7
v_mov_b32 v44, s7
v_not_b32 v45, s7
s_add_u32 s16, s17, 36864
s_mov_b64 exec, 1
s_waitcnt vmcnt(0)
ds_add_u32 v13, v60 offset:2088
s_mov_b64 exec, -1
s_mov_b32 s22, 33554432
L_RU:
ds_read_b32 v14, v13 offset:2088
s_waitcnt lgkmcnt(0)
v_readfirstlane_b32 s23, v14
s_cmp_ge_u32 s23, 10
s_cbranch_scc1 L_RU_D
s_sleep 1
s_sub_u32 s22, s22, 1
s_cbranch_scc0 L_RU
L_RU_D:
s_memrealtime s[12:13]
s_waitcnt lgkmcnt(0)
s_sub_u32 s12, s12, 145
v_mov_b32 v59, s12
ds_read2_b64 v[16:19], v15 offset0:0 offset1:4
ds_read_b64_tr_b16 v[100:101], v56 offset:0
ds_read_b64_tr_b16 v[102:103], v56 offset:2048
ds_read2_b64 v[20:23], v15 offset0:8 offset1:12
ds_read_b64_tr_b16 v[104:105], v56 offset:4096
ds_read_b64_tr_b16 v[106:107], v56 offset:6144
ds_read2_b64 v[24:27], v15 offset0:16 offset1:20
ds_read_b64_tr_b16 v[108:109], v56 offset:8192
ds_read_b64_tr_b16 v[110:111], v56 offset:10240
ds_read2_b64 v[28:31], v15 offset0:24 offset1:28
ds_read_b64_tr_b16 v[112:113], v56 offset:12288
ds_read_b64_tr_b16 v[114:115], v56 offset:14336
ds_read_b64 v[32:33], v15 offset:256
ds_read_b64_tr_b16 v[116:117], v56 offset:16384
s_waitcnt lgkmcnt(11)
v_mfma_f32_16x16x32_bf16 v[40:43], v[16:19], v[100:103], 0
s_waitcnt lgkmcnt(8)
v_mfma_f32_16x16x32_bf16 v[40:43], v[20:23], v[104:107], v[40:43]
s_waitcnt lgkmcnt(5)
v_mfma_f32_16x16x32_bf16 v[40:43], v[24:27], v[108:111], v[40:43]
s_waitcnt lgkmcnt(2)
v_mfma_f32_16x16x32_bf16 v[40:43], v[28:31], v[112:115], v[40:43]
s_waitcnt lgkmcnt(0)
v_mfma_f32_16x16x32_bf16 v[40:43], v[32:35], v[116:119], v[40:43]
s_mov_b64 exec, 0xffff
s_nop 6
buffer_store_dwordx4 v[38:41], v55, s[40:43], s17 offen sc1
buffer_store_dwordx4 v[42:45], v55, s[40:43], s16 offen sc1
s_mov_b64 exec, 1
ds_add_rtn_u32 v14, v13, v60 offset:2072
s_waitcnt lgkmcnt(0)
v_readfirstlane_b32 s23, v14
s_cmp_lg_u32 s23, 3
s_cbranch_scc1 L_XNF
s_mov_b64 exec, s[8:9]
buffer_store_dwordx2 v[58:59], v57, s[40:43], s18 offen sc1
L_XNF:
s_branch L_XEND
L_NOX:
s_waitcnt lgkmcnt(0)
s_add_u32 s60, s7, 1
s_and_b32 s60, s60, 0xff
s_add_u32 s61, s7, 80
s_and_b32 s61, s61, 0xff
s_add_u32 s62, s7, 159
s_and_b32 s62, s62, 0xff
s_add_u32 s63, s7, 238
s_and_b32 s63, s63, 0xff
s_mul_i32 s7, s7, 0x9E3779B1
s_add_u32 s7, s7, 0x7F4A7C15
L_XEND:
s_setprio 0
s_mov_b64 exec, -1
v_mul_u32_u24 v15, 576, v3
v_lshl_add_u32 v15, v4, 2, v15
s_lshl_b32 s12, s6, 6
s_add_u32 s12, s12, 122368
v_add_u32 v15, s12, v15
v_lshl_add_u32 v56, v3, 2, v7
v_mul_u32_u24 v56, 48, v56
s_and_b32 s12, s4, 3
s_cmp_ge_u32 s12, 1
s_cselect_b64 s[14:15], -1, 0
s_cmp_ge_u32 s12, 2
s_cselect_b64 s[16:17], -1, 0
s_cmp_ge_u32 s12, 3
s_cselect_b64 s[18:19], -1, 0
v_lshlrev_b32 v57, 1, v4
s_lshl_b32 s12, s6, 5
v_add_u32 v57, s12, v57
s_mov_b32 s22, 33554432
L_RU2:
ds_read_b32 v14, v13 offset:2048
s_waitcnt lgkmcnt(0)
v_readfirstlane_b32 s23, v14
s_cmp_ge_u32 s23, 2
s_cbranch_scc1 L_RU2_D
s_sleep 1
s_sub_u32 s22, s22, 1
s_cbranch_scc0 L_RU2
L_RU2_D:
ds_read_u16 v64, v57 offset:2304
ds_read_u16 v67, v57 offset:3328
ds_read_u16 v65, v57 offset:2592
ds_read_u16 v68, v57 offset:3616
ds_read_u16 v66, v57 offset:2880
ds_read_u16 v69, v57 offset:3904
s_waitcnt lgkmcnt(0)
v_lshlrev_b32 v64, 16, v64
v_lshlrev_b32 v65, 16, v65
v_lshlrev_b32 v66, 16, v66
v_lshlrev_b32 v67, 16, v67
v_lshlrev_b32 v68, 16, v68
v_lshlrev_b32 v69, 16, v69
v_cndmask_b32 v71, v64, v65, s[18:19]
v_cndmask_b32 v80, v67, v68, s[18:19]
v_cndmask_b32 v72, v64, v65, s[16:17]
v_cndmask_b32 v81, v67, v68, s[16:17]
v_cndmask_b32 v73, v64, v65, s[14:15]
v_cndmask_b32 v82, v67, v68, s[14:15]
v_cndmask_b32 v75, v65, v66, s[18:19]
v_cndmask_b32 v84, v68, v69, s[18:19]
v_cndmask_b32 v76, v65, v66, s[16:17]
v_cndmask_b32 v85, v68, v69, s[16:17]
v_cndmask_b32 v77, v65, v66, s[14:15]
v_cndmask_b32 v86, v68, v69, s[14:15]
v_mov_b32 v45, 0
v_mov_b32 v46, 0
v_mov_b32 v47, 0
v_mov_b32 v109, 0
v_mov_b32 v110, 0
v_mov_b32 v111, 0
s_lshl_b32 s19, s6, 8
s_mov_b32 s18, s66
s_mul_i32 s17, s5, 8*2304
s_add_u32 s17, s17, s19
s_add_u32 s17, s17, 196608
v_lshlrev_b32 v61, 7, v2
v_mov_b32 v62, s7
s_lshl_b32 s16, s5, 10
s_lshl_b32 s19, s4, 2
s_add_u32 s16, s16, s19
s_add_u32 s16, s16, 8224
s_mov_b32 s22, 33554432
L_RQ:
ds_read_b32 v14, v13 offset:2052
s_waitcnt lgkmcnt(0)
v_readfirstlane_b32 s23, v14
s_cmp_ge_u32 s23, 1
s_cbranch_scc1 L_RQ_D
s_sleep 1
s_sub_u32 s22, s22, 1
s_cbranch_scc0 L_RQ
L_RQ_D:
ds_read2st64_b32 v[16:17], v15 offset0:0 offset1:9
ds_read2st64_b32 v[18:19], v15 offset0:18 offset1:27
ds_read2st64_b32 v[20:21], v15 offset0:36 offset1:45
ds_read2st64_b32 v[22:23], v15 offset0:54 offset1:63
ds_read2st64_b32 v[24:25], v15 offset0:72 offset1:81
ds_read2st64_b32 v[26:27], v15 offset0:90 offset1:99
ds_read2st64_b32 v[28:29], v15 offset0:108 offset1:117
ds_read2st64_b32 v[30:31], v15 offset0:126 offset1:135
ds_read2st64_b32 v[32:33], v15 offset0:144 offset1:153
s_waitcnt lgkmcnt(8)
v_cvt_f32_i32 v16, v16
v_cvt_f32_i32 v17, v17
v_cvt_pk_bf16_f32 v17, v16, v17
v_lshlrev_b32 v16, 16, v17
v_and_b32 v17, 0xffff0000, v17
v_sub_f32 v16, v16, v67
v_sub_f32 v17, v17, v67
v_cvt_pk_bf16_f32 v17, v16, v17
v_lshlrev_b32 v16, 16, v17
v_and_b32 v17, 0xffff0000, v17
v_mul_f32 v16, v16, v64
v_mul_f32 v17, v17, v64
v_cvt_pk_bf16_f32 v36, v16, v17
s_waitcnt lgkmcnt(7)
v_cvt_f32_i32 v18, v18
v_cvt_f32_i32 v19, v19
v_cvt_pk_bf16_f32 v19, v18, v19
v_lshlrev_b32 v18, 16, v19
v_and_b32 v19, 0xffff0000, v19
v_sub_f32 v18, v18, v80
v_sub_f32 v19, v19, v80
v_cvt_pk_bf16_f32 v19, v18, v19
v_lshlrev_b32 v18, 16, v19
v_and_b32 v19, 0xffff0000, v19
v_mul_f32 v18, v18, v71
v_mul_f32 v19, v19, v71
v_cvt_pk_bf16_f32 v37, v18, v19
s_waitcnt lgkmcnt(6)
v_cvt_f32_i32 v20, v20
v_cvt_f32_i32 v21, v21
v_cvt_pk_bf16_f32 v21, v20, v21
v_lshlrev_b32 v20, 16, v21
v_and_b32 v21, 0xffff0000, v21
v_sub_f32 v20, v20, v81
v_sub_f32 v21, v21, v81
v_cvt_pk_bf16_f32 v21, v20, v21
v_lshlrev_b32 v20, 16, v21
v_and_b32 v21, 0xffff0000, v21
v_mul_f32 v20, v20, v72
v_mul_f32 v21, v21, v72
v_cvt_pk_bf16_f32 v38, v20, v21
s_waitcnt lgkmcnt(5)
v_cvt_f32_i32 v22, v22
v_cvt_f32_i32 v23, v23
v_cvt_pk_bf16_f32 v23, v22, v23
v_lshlrev_b32 v22, 16, v23
v_and_b32 v23, 0xffff0000, v23
v_sub_f32 v22, v22, v82
v_sub_f32 v23, v23, v82
v_cvt_pk_bf16_f32 v23, v22, v23
v_lshlrev_b32 v22, 16, v23
v_and_b32 v23, 0xffff0000, v23
v_mul_f32 v22, v22, v73
v_mul_f32 v23, v23, v73
v_cvt_pk_bf16_f32 v39, v22, v23
s_waitcnt lgkmcnt(4)
v_cvt_f32_i32 v24, v24
v_cvt_f32_i32 v25, v25
v_cvt_pk_bf16_f32 v25, v24, v25
v_lshlrev_b32 v24, 16, v25
v_and_b32 v25, 0xffff0000, v25
v_sub_f32 v24, v24, v68
v_sub_f32 v25, v25, v68
v_cvt_pk_bf16_f32 v25, v24, v25
v_lshlrev_b32 v24, 16, v25
v_and_b32 v25, 0xffff0000, v25
v_mul_f32 v24, v24, v65
v_mul_f32 v25, v25, v65
v_cvt_pk_bf16_f32 v40, v24, v25
s_waitcnt lgkmcnt(3)
v_cvt_f32_i32 v26, v26
v_cvt_f32_i32 v27, v27
v_cvt_pk_bf16_f32 v27, v26, v27
v_lshlrev_b32 v26, 16, v27
v_and_b32 v27, 0xffff0000, v27
v_sub_f32 v26, v26, v84
v_sub_f32 v27, v27, v84
v_cvt_pk_bf16_f32 v27, v26, v27
v_lshlrev_b32 v26, 16, v27
v_and_b32 v27, 0xffff0000, v27
v_mul_f32 v26, v26, v75
v_mul_f32 v27, v27, v75
v_cvt_pk_bf16_f32 v41, v26, v27
s_waitcnt lgkmcnt(2)
v_cvt_f32_i32 v28, v28
v_cvt_f32_i32 v29, v29
v_cvt_pk_bf16_f32 v29, v28, v29
v_lshlrev_b32 v28, 16, v29
v_and_b32 v29, 0xffff0000, v29
v_sub_f32 v28, v28, v85
v_sub_f32 v29, v29, v85
v_cvt_pk_bf16_f32 v29, v28, v29
v_lshlrev_b32 v28, 16, v29
v_and_b32 v29, 0xffff0000, v29
v_mul_f32 v28, v28, v76
v_mul_f32 v29, v29, v76
v_cvt_pk_bf16_f32 v42, v28, v29
s_waitcnt lgkmcnt(1)
v_cvt_f32_i32 v30, v30
v_cvt_f32_i32 v31, v31
v_cvt_pk_bf16_f32 v31, v30, v31
v_lshlrev_b32 v30, 16, v31
v_and_b32 v31, 0xffff0000, v31
v_sub_f32 v30, v30, v86
v_sub_f32 v31, v31, v86
v_cvt_pk_bf16_f32 v31, v30, v31
v_lshlrev_b32 v30, 16, v31
v_and_b32 v31, 0xffff0000, v31
v_mul_f32 v30, v30, v77
v_mul_f32 v31, v31, v77
v_cvt_pk_bf16_f32 v43, v30, v31
s_waitcnt lgkmcnt(0)
s_mov_b64 exec, 1
ds_add_u32 v13, v60 offset:2068
s_mov_b64 exec, -1
v_cvt_f32_i32 v32, v32
v_cvt_f32_i32 v33, v33
v_cvt_pk_bf16_f32 v33, v32, v33
v_lshlrev_b32 v32, 16, v33
v_and_b32 v33, 0xffff0000, v33
v_sub_f32 v32, v32, v69
v_sub_f32 v33, v33, v69
v_cvt_pk_bf16_f32 v33, v32, v33
v_lshlrev_b32 v32, 16, v33
v_and_b32 v33, 0xffff0000, v33
v_mul_f32 v32, v32, v66
v_mul_f32 v33, v33, v66
v_cvt_pk_bf16_f32 v44, v32, v33
s_mov_b32 s22, 33554432
L_RX:
ds_read_b32 v14, v13 offset:2056
s_waitcnt lgkmcnt(0)
v_readfirstlane_b32 s23, v14
s_cmp_ge_u32 s23, 1
s_cbranch_scc1 L_RX_D
s_sleep 1
s_sub_u32 s22, s22, 1
s_cbranch_scc0 L_RX
L_RX_D:
ds_read_b128 v[100:103], v56 offset:0
ds_read_b128 v[104:107], v56 offset:16
ds_read_b32 v108, v56 offset:32
s_waitcnt lgkmcnt(2)
v_mfma_f32_16x16x32_bf16 v[48:51], v[100:103], v[36:39], 0
s_waitcnt lgkmcnt(1)
v_mfma_f32_16x16x32_bf16 v[48:51], v[104:107], v[40:43], v[48:51]
s_waitcnt lgkmcnt(0)
v_mfma_f32_16x16x32_bf16 v[48:51], v[108:111], v[44:47], v[48:51]
s_mov_b64 exec, 0xffff
s_cmp_eq_u32 s23, 2
s_nop 5
v_or_b32 v48, 1, v48
v_or_b32 v49, 1, v49
v_or_b32 v50, 1, v50
v_or_b32 v51, 1, v51
s_cbranch_scc0 L_HGL
buffer_store_dwordx4 v[48:51], v55, s[40:43], s18 offen
s_branch L_HNF
L_HGL:
buffer_store_dwordx4 v[48:51], v55, s[40:43], s18 offen sc1
s_mov_b64 exec, 1
s_waitcnt vmcnt(0)
ds_add_rtn_u32 v14, v13, v60 offset:2076
s_waitcnt lgkmcnt(0)
v_readfirstlane_b32 s23, v14
s_cmp_lg_u32 s23, 8
s_cbranch_scc1 L_HNF
s_mov_b64 exec, 0xff
buffer_store_dword v62, v61, s[40:43], s16 offen sc1
L_HNF:
s_mov_b64 exec, -1
s_lshl_b32 s21, s6, 7
s_add_u32 s20, s20, s21
s_add_u32 s20, s20, 1253376
v_mov_b32 v118, v11
v_mul_u32_u24 v96, 2304, v10
v_lshl_add_u32 v96, v8, 4, v96
v_lshrrev_b32 v58, 2, v8
v_lshlrev_b32 v58, 6, v58
v_lshl_add_u32 v58, v7, 4, v58
v_and_b32 v59, 3, v8
v_lshl_add_u32 v58, v59, 1, v58
s_lshr_b32 s18, s6, 1
s_lshl_b32 s18, s18, 8
s_and_b32 s19, s6, 1
s_lshl_b32 s19, s19, 3
s_add_u32 s18, s18, s19
v_add_u32 v97, s18, v58
v_mov_b32 v9, v55
v_mov_b32 v15, v60
v_mul_u32_u24 v98, 9216, v90
v_add_u32 v98, v98, v88
s_lshl_b32 s18, s6, 10
s_add_u32 s18, s18, 7168
v_add_u32 v98, s18, v98
v_xor_b32 v99, 0, v89
v_lshl_add_u32 v100, v99, 5, v98
v_add_u32 v104, 73728, v100
v_xor_b32 v99, 1, v89
v_lshl_add_u32 v101, v99, 5, v98
v_add_u32 v105, 73728, v101
v_xor_b32 v99, 2, v89
v_lshl_add_u32 v102, v99, 5, v98
v_add_u32 v106, 73728, v102
v_xor_b32 v99, 3, v89
v_lshl_add_u32 v103, v99, 5, v98
v_add_u32 v107, 73728, v103
v_add_u32 v99, s18, v9
v_lshlrev_b32 v98, 6, v3
v_lshl_add_u32 v98, v7, 4, v98
v_mov_b32 v34, 0
v_mov_b32 v35, 0
v_mov_b32 v117, 0x80
s_lshl_b32 s16, s4, 5
s_add_u32 s14, s16, s5
s_mul_i32 s14, s14, 9216
s_lshl_b32 s19, s6, 10
s_add_u32 s14, s14, s19
s_add_u32 s14, s14, 1048576
v_subrev_u32 v8, 128, v0
v_mul_u32_u24 v10, 3641, v8
v_lshrrev_b32 v10, 16, v10
v_mul_u32_u24 v10, 8928, v10
v_lshlrev_b32 v11, 4, v8
v_add_u32 v10, v10, v11
s_and_b32 s12, s2, 7
s_lshr_b32 s13, s2, 3
s_mul_i32 s16, s12, 32*9216
s_mul_i32 s19, s13, 288
s_add_u32 s16, s16, s19
s_add_u32 s16, s16, 1048576
v_and_b32 v1, 7, v8
v_mul_u32_u24 v1, 288, v1
v_lshrrev_b32 v8, 3, v8
v_lshl_add_u32 v1, v8, 2, v1
v_add_u32 v1, 7168, v1
v_and_b32 v12, 3, v8
v_mul_u32_u24 v12, 9216, v12
v_lshrrev_b32 v8, 2, v8
v_lshl_add_u32 v12, v8, 1, v12
s_mul_i32 s15, s12, 1152
s_mul_i32 s19, s13, 36
s_add_u32 s15, s15, s19
s_mov_b32 s22, 33554432
L_RH:
ds_read_b32 v14, v13 offset:2060
s_waitcnt lgkmcnt(0)
v_readfirstlane_b32 s23, v14
s_cmp_ge_u32 s23, 1
s_cbranch_scc1 L_RH_D
s_sleep 1
s_sub_u32 s22, s22, 1
s_cbranch_scc0 L_RH
L_RH_D:
s_mov_b32 s22, 2097152
L_HPOLL:
buffer_load_dwordx4 v[48:51], v96, s[40:43], s17 offen sc1
buffer_load_dwordx4 v[52:55], v96, s[40:43], s17 offen offset:128 sc1
s_waitcnt vmcnt(0)
v_and_b32 v56, v48, v52
v_and_b32 v57, v49, v53
v_and_b32 v58, v50, v54
v_and_b32 v59, v51, v55
v_and_b32 v56, v56, v57
v_and_b32 v58, v58, v59
v_and_b32 v56, v56, v58
v_and_b32 v56, 1, v56
v_cmp_eq_u32 vcc, 0, v56
s_and_b64 exec, vcc, vcc
s_cbranch_scc0 L_HDONE
s_sub_u32 s22, s22, 1
s_cbranch_scc0 L_HPOLL
L_HDONE:
s_mov_b64 exec, -1
buffer_load_dwordx4 v[112:115], v118, s[36:39], s20 offen nt
v_add_f32_dpp v48, v48, v48 quad_perm:[1,0,3,2] row_mask:0xf bank_mask:0xf
v_add_f32_dpp v49, v49, v49 quad_perm:[1,0,3,2] row_mask:0xf bank_mask:0xf
v_add_f32_dpp v50, v50, v50 quad_perm:[1,0,3,2] row_mask:0xf bank_mask:0xf
v_add_f32_dpp v51, v51, v51 quad_perm:[1,0,3,2] row_mask:0xf bank_mask:0xf
v_add_f32_dpp v52, v52, v52 quad_perm:[1,0,3,2] row_mask:0xf bank_mask:0xf
v_add_f32_dpp v53, v53, v53 quad_perm:[1,0,3,2] row_mask:0xf bank_mask:0xf
v_add_f32_dpp v54, v54, v54 quad_perm:[1,0,3,2] row_mask:0xf bank_mask:0xf
v_add_f32_dpp v55, v55, v55 quad_perm:[1,0,3,2] row_mask:0xf bank_mask:0xf
v_add_f32_dpp v48, v48, v48 quad_perm:[2,3,0,1] row_mask:0xf bank_mask:0xf
v_add_f32_dpp v49, v49, v49 quad_perm:[2,3,0,1] row_mask:0xf bank_mask:0xf
v_add_f32_dpp v50, v50, v50 quad_perm:[2,3,0,1] row_mask:0xf bank_mask:0xf
v_add_f32_dpp v51, v51, v51 quad_perm:[2,3,0,1] row_mask:0xf bank_mask:0xf
v_add_f32_dpp v52, v52, v52 quad_perm:[2,3,0,1] row_mask:0xf bank_mask:0xf
v_add_f32_dpp v53, v53, v53 quad_perm:[2,3,0,1] row_mask:0xf bank_mask:0xf
v_add_f32_dpp v54, v54, v54 quad_perm:[2,3,0,1] row_mask:0xf bank_mask:0xf
v_add_f32_dpp v55, v55, v55 quad_perm:[2,3,0,1] row_mask:0xf bank_mask:0xf
v_add_f32_dpp v48, v48, v48 row_half_mirror row_mask:0xf bank_mask:0xf
v_add_f32_dpp v49, v49, v49 row_half_mirror row_mask:0xf bank_mask:0xf
v_add_f32_dpp v50, v50, v50 row_half_mirror row_mask:0xf bank_mask:0xf
v_add_f32_dpp v51, v51, v51 row_half_mirror row_mask:0xf bank_mask:0xf
v_add_f32_dpp v52, v52, v52 row_half_mirror row_mask:0xf bank_mask:0xf
v_add_f32_dpp v53, v53, v53 row_half_mirror row_mask:0xf bank_mask:0xf
v_add_f32_dpp v54, v54, v54 row_half_mirror row_mask:0xf bank_mask:0xf
v_add_f32_dpp v55, v55, v55 row_half_mirror row_mask:0xf bank_mask:0xf
v_cndmask_b32 v48, v48, v49, s[56:57]
v_cndmask_b32 v48, v48, v50, s[58:59]
v_cndmask_b32 v48, v48, v51, s[64:65]
v_cndmask_b32 v52, v52, v53, s[56:57]
v_cndmask_b32 v52, v52, v54, s[58:59]
v_cndmask_b32 v52, v52, v55, s[64:65]
v_cvt_pk_bf16_f32 v48, v48, v52
ds_write_b16 v97, v48 offset:768
ds_write_b16_d16_hi v97, v48 offset:896
s_mov_b64 exec, 1
ds_add_u32 v13, v15 offset:2064
s_mov_b64 exec, -1
s_mov_b32 s22, 33554432
L_CA:
ds_read_b32 v14, v13 offset:2064
s_waitcnt lgkmcnt(0)
v_readfirstlane_b32 s23, v14
s_cmp_ge_u32 s23, 9
s_cbranch_scc1 L_CA_D
s_sleep 1
s_sub_u32 s22, s22, 1
s_cbranch_scc0 L_CA
L_CA_D:
ds_read_b128 v[16:19], v98 offset:768
ds_read_b128 v[20:23], v98 offset:1024
ds_read_b128 v[24:27], v98 offset:1280
ds_read_b128 v[28:31], v98 offset:1536
ds_read_b64 v[32:33], v98 offset:1792
s_mov_b32 s22, 33554432
L_EB:
ds_read_b32 v14, v13 offset:2084
s_waitcnt lgkmcnt(0)
v_readfirstlane_b32 s23, v14
s_cmp_ge_u32 s23, 13
s_cbranch_scc1 L_EB_D
s_sleep 1
s_sub_u32 s22, s22, 1
s_cbranch_scc0 L_EB
L_EB_D:
ds_read_b64_tr_b16 v[48:49], v100 offset:9216
ds_read_b64_tr_b16 v[50:51], v100 offset:27648
ds_read_b64_tr_b16 v[52:53], v101 offset:9216
ds_read_b64_tr_b16 v[54:55], v101 offset:27648
ds_read_b64_tr_b16 v[56:57], v102 offset:9216
ds_read_b64_tr_b16 v[58:59], v102 offset:27648
ds_read_b64_tr_b16 v[60:61], v103 offset:9216
ds_read_b64_tr_b16 v[62:63], v103 offset:27648
ds_read_b64_tr_b16 v[64:65], v100 offset:46080
ds_read_b64_tr_b16 v[66:67], v100 offset:64512
ds_read_b64_tr_b16 v[68:69], v101 offset:46080
ds_read_b64_tr_b16 v[70:71], v101 offset:64512
ds_read_b64_tr_b16 v[72:73], v102 offset:46080
ds_read_b64_tr_b16 v[74:75], v102 offset:64512
ds_read_b64_tr_b16 v[76:77], v103 offset:46080
ds_read_b64_tr_b16 v[78:79], v103 offset:64512
v_mov_b32 v82, 0
v_mov_b32 v83, 0
v_mov_b32 v86, 0
v_mov_b32 v87, 0
v_mov_b32 v90, 0
v_mov_b32 v91, 0
v_mov_b32 v94, 0
v_mov_b32 v95, 0
s_waitcnt lgkmcnt(8)
v_mfma_f32_16x16x32_bf16 v[36:39], v[16:19], v[48:51], 0
v_mfma_f32_16x16x32_bf16 v[40:43], v[16:19], v[52:55], 0
v_mfma_f32_16x16x32_bf16 v[44:47], v[16:19], v[56:59], 0
v_mfma_f32_16x16x32_bf16 v[120:123], v[16:19], v[60:63], 0
s_waitcnt lgkmcnt(0)
v_mfma_f32_16x16x32_bf16 v[36:39], v[20:23], v[64:67], v[36:39]
v_mfma_f32_16x16x32_bf16 v[40:43], v[20:23], v[68:71], v[40:43]
v_mfma_f32_16x16x32_bf16 v[44:47], v[20:23], v[72:75], v[44:47]
v_mfma_f32_16x16x32_bf16 v[120:123], v[20:23], v[76:79], v[120:123]
s_mov_b32 s22, 2097152
s_barrier
ds_read_b64_tr_b16 v[48:49], v104 offset:9216
ds_read_b64_tr_b16 v[50:51], v104 offset:27648
ds_read_b64_tr_b16 v[52:53], v105 offset:9216
ds_read_b64_tr_b16 v[54:55], v105 offset:27648
ds_read_b64_tr_b16 v[56:57], v106 offset:9216
ds_read_b64_tr_b16 v[58:59], v106 offset:27648
ds_read_b64_tr_b16 v[60:61], v107 offset:9216
ds_read_b64_tr_b16 v[62:63], v107 offset:27648
s_waitcnt vmcnt(0)
ds_write_b128 v99, v[112:115] offset:9216
ds_read_b64_tr_b16 v[80:81], v100
ds_read_b64_tr_b16 v[84:85], v101
ds_read_b64_tr_b16 v[88:89], v102
ds_read_b64_tr_b16 v[92:93], v103
s_waitcnt lgkmcnt(5)
v_mfma_f32_16x16x32_bf16 v[36:39], v[24:27], v[48:51], v[36:39]
v_mfma_f32_16x16x32_bf16 v[40:43], v[24:27], v[52:55], v[40:43]
v_mfma_f32_16x16x32_bf16 v[44:47], v[24:27], v[56:59], v[44:47]
v_mfma_f32_16x16x32_bf16 v[120:123], v[24:27], v[60:63], v[120:123]
s_waitcnt lgkmcnt(0)
v_mfma_f32_16x16x32_bf16 v[36:39], v[32:35], v[80:83], v[36:39]
v_mfma_f32_16x16x32_bf16 v[40:43], v[32:35], v[84:87], v[40:43]
v_mfma_f32_16x16x32_bf16 v[44:47], v[32:35], v[88:91], v[44:47]
v_mfma_f32_16x16x32_bf16 v[120:123], v[32:35], v[92:95], v[120:123]
s_barrier
ds_read_b64_tr_b16 v[64:65], v104 offset:46080
ds_read_b64_tr_b16 v[66:67], v104 offset:64512
ds_read_b64_tr_b16 v[68:69], v105 offset:46080
ds_read_b64_tr_b16 v[70:71], v105 offset:64512
ds_read_b64_tr_b16 v[72:73], v106 offset:46080
ds_read_b64_tr_b16 v[74:75], v106 offset:64512
ds_read_b64_tr_b16 v[76:77], v107 offset:46080
ds_read_b64_tr_b16 v[78:79], v107 offset:64512
s_waitcnt lgkmcnt(6)
v_mfma_f32_16x16x32_bf16 v[36:39], v[28:31], v[64:67], v[36:39]
s_waitcnt lgkmcnt(4)
v_mfma_f32_16x16x32_bf16 v[40:43], v[28:31], v[68:71], v[40:43]
s_waitcnt lgkmcnt(2)
v_mfma_f32_16x16x32_bf16 v[44:47], v[28:31], v[72:75], v[44:47]
s_waitcnt lgkmcnt(0)
v_mfma_f32_16x16x32_bf16 v[120:123], v[28:31], v[76:79], v[120:123]
s_nop 1
v_add_u32_dpp v108, v36, v117 quad_perm:[0,1,2,3] row_mask:0x1 bank_mask:0xf
v_add_u32_dpp v109, v37, v117 quad_perm:[0,1,2,3] row_mask:0x1 bank_mask:0xf
v_add_u32_dpp v110, v38, v117 quad_perm:[0,1,2,3] row_mask:0x1 bank_mask:0xf
v_add_u32_dpp v111, v39, v117 quad_perm:[0,1,2,3] row_mask:0x1 bank_mask:0xf
v_add_u32_dpp v108, v40, v117 quad_perm:[0,1,2,3] row_mask:0x2 bank_mask:0xf
v_add_u32_dpp v109, v41, v117 quad_perm:[0,1,2,3] row_mask:0x2 bank_mask:0xf
v_add_u32_dpp v110, v42, v117 quad_perm:[0,1,2,3] row_mask:0x2 bank_mask:0xf
v_add_u32_dpp v111, v43, v117 quad_perm:[0,1,2,3] row_mask:0x2 bank_mask:0xf
v_add_u32_dpp v108, v44, v117 quad_perm:[0,1,2,3] row_mask:0x4 bank_mask:0xf
v_add_u32_dpp v109, v45, v117 quad_perm:[0,1,2,3] row_mask:0x4 bank_mask:0xf
v_add_u32_dpp v110, v46, v117 quad_perm:[0,1,2,3] row_mask:0x4 bank_mask:0xf
v_add_u32_dpp v111, v47, v117 quad_perm:[0,1,2,3] row_mask:0x4 bank_mask:0xf
v_add_u32_dpp v108, v120, v117 quad_perm:[0,1,2,3] row_mask:0x8 bank_mask:0xf
v_add_u32_dpp v109, v121, v117 quad_perm:[0,1,2,3] row_mask:0x8 bank_mask:0xf
v_add_u32_dpp v110, v122, v117 quad_perm:[0,1,2,3] row_mask:0x8 bank_mask:0xf
v_add_u32_dpp v111, v123, v117 quad_perm:[0,1,2,3] row_mask:0x8 bank_mask:0xf
v_and_or_b32 v108, v108, v5, s60
v_and_or_b32 v109, v109, v5, s61
v_and_or_b32 v110, v110, v5, s62
v_and_or_b32 v111, v111, v5, s63
buffer_store_dwordx4 v[108:111], v9, s[40:43], s14 offen sc1
s_barrier
buffer_load_dwordx4 v[112:115], v10, s[40:43], s16 offen sc1
L_YCHK:
s_waitcnt vmcnt(0)
v_xor_b32 v112, s60, v112
v_xor_b32 v113, s61, v113
v_xor_b32 v114, s62, v114
v_xor_b32 v115, s63, v115
v_or3_b32 v116, v112, v113, v114
v_or_b32 v116, v116, v115
v_and_b32 v116, 0xff, v116
v_cmp_ne_u32 vcc, 0, v116
s_cbranch_vccnz L_YRETRY
L_YDONE:
s_mov_b64 exec, -1
ds_write_b128 v11, v[112:115] offset:7168
s_waitcnt lgkmcnt(0)
s_barrier
ds_read2st64_b32 v[112:113], v1 offset0:0 offset1:9
ds_read2st64_b32 v[114:115], v1 offset0:18 offset1:27
s_waitcnt lgkmcnt(0)
v_add_f32 v112, v112, v113
v_add_f32 v114, v114, v115
v_add_f32 v112, v112, v114
s_nop 1
v_add_f32_dpp v112, v112, v112 quad_perm:[1,0,3,2] row_mask:0xf bank_mask:0xf
s_nop 1
v_add_f32_dpp v112, v112, v112 quad_perm:[2,3,0,1] row_mask:0xf bank_mask:0xf
s_nop 1
v_add_f32_dpp v112, v112, v112 row_half_mirror row_mask:0xf bank_mask:0xf
v_cvt_pk_bf16_f32 v112, v112, v112
s_mov_b32 exec_lo, 0x01010101
s_mov_b32 exec_hi, 0x01010101
buffer_store_short v112, v12, s[44:47], s15 offen
s_or_b32 s19, s2, s6
s_cbranch_scc1 L_CEND
s_mov_b64 exec, 1
v_mov_b32 v14, s7
buffer_store_dword v14, v13, s[40:43], 0 offen offset:0
L_CEND:
s_endpgm
L_YRETRY:
s_sub_u32 s22, s22, 1
s_cbranch_scc1 L_YDONE
s_mov_b64 exec, vcc
s_sleep 2
buffer_load_dwordx4 v[112:115], v10, s[40:43], s16 offen sc1
s_branch L_YCHK
L_CODE_END:
.section .rodata,"a"
.p2align 6
.amdhsa_kernel standalone__weight_only_int_quip__decode_kernel
  .amdhsa_next_free_vgpr 128
  .amdhsa_next_free_sgpr 70
  .amdhsa_accum_offset 128
  .amdhsa_group_segment_fixed_size 0
  .amdhsa_kernarg_size 72
  .amdhsa_user_sgpr_count 2
  .amdhsa_user_sgpr_kernarg_segment_ptr 1
  .amdhsa_system_sgpr_workgroup_id_x 1
  .amdhsa_float_denorm_mode_32 3
.end_amdhsa_kernel
```
